```python
import torch

def _softmax(x, axis=-1):
    return torch.softmax(x, dim=axis)
def _gelu(x):
    return torch.nn.functional.gelu(x, approximate="tanh")
def _silu(x):
    return torch.nn.functional.silu(x)
def _sigmoid(x):
    return torch.sigmoid(x)
def _layernorm(x, axis=-1, eps=1e-5):
    m = x.mean(dim=axis, keepdim=True)
    v = x.var(dim=axis, keepdim=True, unbiased=False)
    return (x - m) / torch.sqrt(v + eps)
def _scatter_add(tgt, idx, src, axis=0):
    return tgt.clone().index_add_(axis, idx, src)
def _segment_sum(src, seg, n):
    out = torch.zeros((n,) + src.shape[1:], dtype=src.dtype)
    return out.index_add_(0, seg, src)
def _pad(x, pw):
    flat = tuple(v for pair in reversed(pw) for v in pair)
    return torch.nn.functional.pad(x, flat)

kernel_name = 'standalone__softmax_full_bidir__decode'

def setup_inputs():

    _w = (lambda a: (lambda t: t.to(torch.bfloat16) if t.is_floating_point() else t)(torch.as_tensor(a)))
    B, H, Sq, Skv, Dh = 1, 32, 1, 32768, 192
    return {
        "q": _w((lambda *s: torch.randn(*s, dtype=torch.bfloat16) * 0.8)(B, H, Sq, Dh)),
        "k": _w((lambda *s: torch.randn(*s, dtype=torch.bfloat16) * 0.8)(B, H, Skv, Dh)),
        "v": _w((lambda *s: torch.randn(*s, dtype=torch.bfloat16) * 0.05)(B, H, Skv, Dh)),
    }

def reference(q, k, v):
    scale = q.shape[-1] ** -0.5
    scores = torch.einsum('bhqd,bhkd->bhqk', q, k) * scale
    attn = _softmax(scores, axis=-1)
    return torch.einsum('bhqk,bhkd->bhqd', attn, v)
```

```asm
; @launch kernel=standalone__softmax_full_bidir__decode_kernel grid=(512,1,1) block=(256,1,1) lds=12288
; @launch kernel=combine_kernel grid=(32,1,1) block=(256,1,1) lds=0
.amdgcn_target "amdgcn-amd-amdhsa--gfx950"
.text
.globl standalone__softmax_full_bidir__decode_kernel
.p2align 8
.type standalone__softmax_full_bidir__decode_kernel,@function
standalone__softmax_full_bidir__decode_kernel:
    s_cmp_ge_u32 s2, 512
    s_cbranch_scc1 L_end1
    s_load_dwordx4 s[4:7], s[0:1], 0
    s_load_dwordx2 s[8:9], s[0:1], 16
    s_load_dwordx2 s[10:11], s[0:1], 40
    v_and_b32 v7, 63, v0
    v_lshrrev_b32 v2, 6, v0
    s_nop 0
    v_readfirstlane_b32 s3, v2
    v_lshrrev_b32 v2, 3, v7
    v_mul_u32_u24 v1, 384, v2
    v_mul_u32_u24 v6, 256, v2
    v_and_b32 v4, 7, v7
    v_lshlrev_b32 v5, 4, v4
    v_add_u32 v1, v1, v5
    s_lshr_b32 s12, s2, 4
    s_and_b32 s13, s2, 15
    s_mul_i32 s14, s12, 12582912
    s_mul_i32 s15, s13, 786432
    s_add_u32 s14, s14, s15
    s_mul_i32 s15, s3, 3072
    s_add_u32 s14, s14, s15
    s_mul_i32 s15, s12, 384
    s_mul_i32 s51, s3, 2048
    v_add_u32 v6, s51, v6
    v_mov_b32 v3, v6
    s_waitcnt lgkmcnt(0)
    s_mov_b32 s16, s4
    s_and_b32 s17, s5, 0xffff
    s_mov_b32 s18, 12288
    s_mov_b32 s19, 0x20000
    s_mov_b32 s20, s6
    s_and_b32 s21, s7, 0xffff
    s_mov_b32 s22, 402653184
    s_mov_b32 s23, 0x20000
    s_and_b32 s9, s9, 0xffff
    s_mov_b32 s28, s10
    s_and_b32 s29, s11, 0xffff
    s_mov_b32 s30, 524288
    s_mov_b32 s31, 0x20000
    buffer_load_dwordx4 v[12:15], v5, s[16:19], s15 offen offset:0
    buffer_load_dwordx4 v[16:19], v5, s[16:19], s15 offen offset:128
    buffer_load_dwordx4 v[20:23], v5, s[16:19], s15 offen offset:256
    s_mov_b32 s40, s14
    buffer_load_dwordx4 v[64:67], v1, s[20:23], s40 offen offset:0 nt
    buffer_load_dwordx4 v[68:71], v1, s[20:23], s40 offen offset:128 nt
    buffer_load_dwordx4 v[72:75], v1, s[20:23], s40 offen offset:256 nt
    s_add_u32 s40, s40, 12288
    buffer_load_dwordx4 v[76:79], v1, s[20:23], s40 offen offset:0 nt
    buffer_load_dwordx4 v[80:83], v1, s[20:23], s40 offen offset:128 nt
    buffer_load_dwordx4 v[84:87], v1, s[20:23], s40 offen offset:256 nt
    s_add_u32 s40, s40, 12288
    buffer_load_dwordx4 v[88:91], v1, s[20:23], s40 offen offset:0 nt
    buffer_load_dwordx4 v[92:95], v1, s[20:23], s40 offen offset:128 nt
    buffer_load_dwordx4 v[96:99], v1, s[20:23], s40 offen offset:256 nt
    s_add_u32 s40, s40, 12288
    buffer_load_dwordx4 v[100:103], v1, s[20:23], s40 offen offset:0 nt
    buffer_load_dwordx4 v[104:107], v1, s[20:23], s40 offen offset:128 nt
    buffer_load_dwordx4 v[108:111], v1, s[20:23], s40 offen offset:256 nt
    s_add_u32 s40, s40, 12288
    s_mov_b32 s41, 0
L_kloop:
    s_cmp_eq_u32 s41, 15
    s_cbranch_scc0 L_k1
    s_mov_b32 s20, s8
    s_mov_b32 s21, s9
    s_mov_b32 s40, s14
L_k1:
    s_waitcnt vmcnt(9)
    v_dot2_f32_bf16 v48, v64, v12, 0
    v_dot2_f32_bf16 v48, v65, v13, v48
    v_dot2_f32_bf16 v48, v66, v14, v48
    v_dot2_f32_bf16 v48, v67, v15, v48
    v_dot2_f32_bf16 v48, v68, v16, v48
    v_dot2_f32_bf16 v48, v69, v17, v48
    v_dot2_f32_bf16 v48, v70, v18, v48
    v_dot2_f32_bf16 v48, v71, v19, v48
    v_dot2_f32_bf16 v48, v72, v20, v48
    v_dot2_f32_bf16 v48, v73, v21, v48
    v_dot2_f32_bf16 v48, v74, v22, v48
    v_dot2_f32_bf16 v48, v75, v23, v48
    buffer_load_dwordx4 v[64:67], v1, s[20:23], s40 offen offset:0 nt
    buffer_load_dwordx4 v[68:71], v1, s[20:23], s40 offen offset:128 nt
    buffer_load_dwordx4 v[72:75], v1, s[20:23], s40 offen offset:256 nt
    s_add_u32 s40, s40, 12288
    s_waitcnt vmcnt(9)
    v_dot2_f32_bf16 v49, v76, v12, 0
    v_dot2_f32_bf16 v49, v77, v13, v49
    v_dot2_f32_bf16 v49, v78, v14, v49
    v_dot2_f32_bf16 v49, v79, v15, v49
    v_add_f32_dpp v48, v48, v48 quad_perm:[1,0,3,2] row_mask:0xf bank_mask:0xf
    v_dot2_f32_bf16 v49, v80, v16, v49
    v_dot2_f32_bf16 v49, v81, v17, v49
    v_dot2_f32_bf16 v49, v82, v18, v49
    v_dot2_f32_bf16 v49, v83, v19, v49
    v_add_f32_dpp v48, v48, v48 quad_perm:[2,3,0,1] row_mask:0xf bank_mask:0xf
    v_dot2_f32_bf16 v49, v84, v20, v49
    v_dot2_f32_bf16 v49, v85, v21, v49
    v_dot2_f32_bf16 v49, v86, v22, v49
    v_dot2_f32_bf16 v49, v87, v23, v49
    v_add_f32_dpp v48, v48, v48 row_half_mirror row_mask:0xf bank_mask:0xf
    buffer_load_dwordx4 v[76:79], v1, s[20:23], s40 offen offset:0 nt
    buffer_load_dwordx4 v[80:83], v1, s[20:23], s40 offen offset:128 nt
    buffer_load_dwordx4 v[84:87], v1, s[20:23], s40 offen offset:256 nt
    s_add_u32 s40, s40, 12288
    s_waitcnt vmcnt(9)
    v_dot2_f32_bf16 v50, v88, v12, 0
    v_dot2_f32_bf16 v50, v89, v13, v50
    v_dot2_f32_bf16 v50, v90, v14, v50
    v_dot2_f32_bf16 v50, v91, v15, v50
    v_add_f32_dpp v49, v49, v49 quad_perm:[1,0,3,2] row_mask:0xf bank_mask:0xf
    v_dot2_f32_bf16 v50, v92, v16, v50
    v_dot2_f32_bf16 v50, v93, v17, v50
    v_dot2_f32_bf16 v50, v94, v18, v50
    v_dot2_f32_bf16 v50, v95, v19, v50
    v_add_f32_dpp v49, v49, v49 quad_perm:[2,3,0,1] row_mask:0xf bank_mask:0xf
    v_dot2_f32_bf16 v50, v96, v20, v50
    v_dot2_f32_bf16 v50, v97, v21, v50
    v_dot2_f32_bf16 v50, v98, v22, v50
    v_dot2_f32_bf16 v50, v99, v23, v50
    v_add_f32_dpp v49, v49, v49 row_half_mirror row_mask:0xf bank_mask:0xf
    buffer_load_dwordx4 v[88:91], v1, s[20:23], s40 offen offset:0 nt
    buffer_load_dwordx4 v[92:95], v1, s[20:23], s40 offen offset:128 nt
    buffer_load_dwordx4 v[96:99], v1, s[20:23], s40 offen offset:256 nt
    s_add_u32 s40, s40, 12288
    s_waitcnt vmcnt(9)
    v_dot2_f32_bf16 v51, v100, v12, 0
    v_dot2_f32_bf16 v51, v101, v13, v51
    v_dot2_f32_bf16 v51, v102, v14, v51
    v_dot2_f32_bf16 v51, v103, v15, v51
    v_add_f32_dpp v50, v50, v50 quad_perm:[1,0,3,2] row_mask:0xf bank_mask:0xf
    v_dot2_f32_bf16 v51, v104, v16, v51
    v_dot2_f32_bf16 v51, v105, v17, v51
    v_dot2_f32_bf16 v51, v106, v18, v51
    v_dot2_f32_bf16 v51, v107, v19, v51
    v_add_f32_dpp v50, v50, v50 quad_perm:[2,3,0,1] row_mask:0xf bank_mask:0xf
    v_dot2_f32_bf16 v51, v108, v20, v51
    v_dot2_f32_bf16 v51, v109, v21, v51
    v_dot2_f32_bf16 v51, v110, v22, v51
    v_dot2_f32_bf16 v51, v111, v23, v51
    v_add_f32_dpp v50, v50, v50 row_half_mirror row_mask:0xf bank_mask:0xf
    buffer_load_dwordx4 v[100:103], v1, s[20:23], s40 offen offset:0 nt
    buffer_load_dwordx4 v[104:107], v1, s[20:23], s40 offen offset:128 nt
    buffer_load_dwordx4 v[108:111], v1, s[20:23], s40 offen offset:256 nt
    s_add_u32 s40, s40, 12288
    s_nop 1
    v_add_f32_dpp v51, v51, v51 quad_perm:[1,0,3,2] row_mask:0xf bank_mask:0xf
    s_nop 1
    v_add_f32_dpp v51, v51, v51 quad_perm:[2,3,0,1] row_mask:0xf bank_mask:0xf
    s_nop 1
    v_add_f32_dpp v51, v51, v51 row_half_mirror row_mask:0xf bank_mask:0xf
    s_add_u32 s41, s41, 1
    s_cmp_lt_u32 s41, 16
    ds_write_b128 v3, v[48:51]
    v_add_u32 v3, 16, v3
    s_cbranch_scc1 L_kloop
    v_and_b32 v2, 7, v7
    v_mul_u32_u24 v2, 32, v2
    v_add_u32 v2, v2, v6
    s_waitcnt lgkmcnt(0)
    ds_read_b128 v[48:51], v2
    ds_read_b128 v[52:55], v2 offset:16
    v_mov_b32 v24, 0
    v_mov_b32 v25, 0
    v_mov_b32 v26, 0
    v_mov_b32 v27, 0
    v_mov_b32 v28, 0
    v_mov_b32 v29, 0
    v_mov_b32 v30, 0
    v_mov_b32 v31, 0
    v_mov_b32 v32, 0
    v_mov_b32 v33, 0
    v_mov_b32 v34, 0
    v_mov_b32 v35, 0
    v_mov_b32 v36, 0
    v_mov_b32 v37, 0
    v_mov_b32 v38, 0
    v_mov_b32 v39, 0
    v_mov_b32 v40, 0
    v_mov_b32 v41, 0
    v_mov_b32 v42, 0
    v_mov_b32 v43, 0
    v_mov_b32 v44, 0
    v_mov_b32 v45, 0
    v_mov_b32 v46, 0
    v_mov_b32 v47, 0
    s_waitcnt lgkmcnt(0)
    v_mov_b32 v9, v48
    v_max_f32 v9, v9, v49
    v_max_f32 v9, v9, v50
    v_max_f32 v9, v9, v51
    v_max_f32 v9, v9, v52
    v_max_f32 v9, v9, v53
    v_max_f32 v9, v9, v54
    v_max_f32 v9, v9, v55
    s_nop 1
    v_max_f32_dpp v9, v9, v9 row_ror:8 row_mask:0xf bank_mask:0xf
    s_nop 1
    v_max_f32_dpp v9, v9, v9 row_ror:4 row_mask:0xf bank_mask:0xf
    s_nop 1
    v_max_f32_dpp v9, v9, v9 row_ror:2 row_mask:0xf bank_mask:0xf
    s_nop 1
    v_max_f32_dpp v9, v9, v9 row_ror:1 row_mask:0xf bank_mask:0xf
    v_mov_b32 v3, v9
    s_nop 1
    v_permlane16_swap_b32 v3, v9
    s_nop 1
    v_max_f32 v9, v9, v3
    v_mov_b32 v3, v9
    s_nop 1
    v_permlane32_swap_b32 v3, v9
    s_nop 1
    v_max_f32 v9, v9, v3
    s_mov_b32 s50, 0x3dd53b95
    v_mul_f32 v3, s50, v9
    v_fma_f32 v48, v48, s50, -v3
    v_fma_f32 v49, v49, s50, -v3
    v_fma_f32 v50, v50, s50, -v3
    v_fma_f32 v51, v51, s50, -v3
    v_fma_f32 v52, v52, s50, -v3
    v_fma_f32 v53, v53, s50, -v3
    v_fma_f32 v54, v54, s50, -v3
    v_fma_f32 v55, v55, s50, -v3
    v_exp_f32 v48, v48
    v_exp_f32 v49, v49
    v_exp_f32 v50, v50
    v_exp_f32 v51, v51
    v_exp_f32 v52, v52
    v_exp_f32 v53, v53
    v_exp_f32 v54, v54
    v_exp_f32 v55, v55
    s_nop 0
    v_cvt_pk_bf16_f32 v48, v48, 0
    v_cvt_pk_bf16_f32 v49, v49, 0
    v_cvt_pk_bf16_f32 v50, v50, 0
    v_cvt_pk_bf16_f32 v51, v51, 0
    v_cvt_pk_bf16_f32 v52, v52, 0
    v_cvt_pk_bf16_f32 v53, v53, 0
    v_cvt_pk_bf16_f32 v54, v54, 0
    v_cvt_pk_bf16_f32 v55, v55, 0
    ds_write_b128 v2, v[48:51]
    ds_write_b128 v2, v[52:55] offset:16
    v_lshlrev_b32 v4, 16, v48
    v_lshlrev_b32 v5, 16, v49
    v_add_f32 v4, v4, v5
    v_lshlrev_b32 v5, 16, v50
    v_add_f32 v4, v4, v5
    v_lshlrev_b32 v5, 16, v51
    v_add_f32 v4, v4, v5
    v_lshlrev_b32 v5, 16, v52
    v_add_f32 v4, v4, v5
    v_lshlrev_b32 v5, 16, v53
    v_add_f32 v4, v4, v5
    v_lshlrev_b32 v5, 16, v54
    v_add_f32 v4, v4, v5
    v_lshlrev_b32 v5, 16, v55
    v_add_f32 v4, v4, v5
    s_nop 1
    v_add_f32_dpp v4, v4, v4 row_ror:8 row_mask:0xf bank_mask:0xf
    s_nop 1
    v_add_f32_dpp v4, v4, v4 row_ror:4 row_mask:0xf bank_mask:0xf
    s_nop 1
    v_add_f32_dpp v4, v4, v4 row_ror:2 row_mask:0xf bank_mask:0xf
    s_nop 1
    v_add_f32_dpp v4, v4, v4 row_ror:1 row_mask:0xf bank_mask:0xf
    v_mov_b32 v3, v4
    s_nop 1
    v_permlane16_swap_b32 v3, v4
    s_nop 1
    v_add_f32 v4, v4, v3
    v_mov_b32 v3, v4
    s_nop 1
    v_permlane32_swap_b32 v3, v4
    s_nop 1
    v_add_f32 v4, v4, v3
    v_mov_b32 v8, v4
    v_mov_b32 v3, v6
    s_waitcnt lgkmcnt(0)
    ds_read_b128 v[56:59], v3
    s_mov_b32 s41, 0
L_vloop:
    s_waitcnt lgkmcnt(0)
    v_mov_b32 v60, v56
    v_mov_b32 v61, v57
    v_mov_b32 v62, v58
    v_mov_b32 v63, v59
    v_add_u32 v3, 16, v3
    ds_read_b128 v[56:59], v3
    v_lshlrev_b32 v2, 16, v60
    s_waitcnt vmcnt(9)
    v_dot2_f32_bf16 v24, v64, v60, v24
    v_dot2_f32_bf16 v25, v64, v2, v25
    v_dot2_f32_bf16 v26, v65, v60, v26
    v_dot2_f32_bf16 v27, v65, v2, v27
    v_dot2_f32_bf16 v28, v66, v60, v28
    v_dot2_f32_bf16 v29, v66, v2, v29
    v_dot2_f32_bf16 v30, v67, v60, v30
    v_dot2_f32_bf16 v31, v67, v2, v31
    v_dot2_f32_bf16 v32, v68, v60, v32
    v_dot2_f32_bf16 v33, v68, v2, v33
    v_dot2_f32_bf16 v34, v69, v60, v34
    v_dot2_f32_bf16 v35, v69, v2, v35
    v_dot2_f32_bf16 v36, v70, v60, v36
    v_dot2_f32_bf16 v37, v70, v2, v37
    v_dot2_f32_bf16 v38, v71, v60, v38
    v_dot2_f32_bf16 v39, v71, v2, v39
    v_dot2_f32_bf16 v40, v72, v60, v40
    v_dot2_f32_bf16 v41, v72, v2, v41
    v_dot2_f32_bf16 v42, v73, v60, v42
    v_dot2_f32_bf16 v43, v73, v2, v43
    v_dot2_f32_bf16 v44, v74, v60, v44
    v_dot2_f32_bf16 v45, v74, v2, v45
    v_dot2_f32_bf16 v46, v75, v60, v46
    v_dot2_f32_bf16 v47, v75, v2, v47
    buffer_load_dwordx4 v[64:67], v1, s[20:23], s40 offen offset:0 nt
    buffer_load_dwordx4 v[68:71], v1, s[20:23], s40 offen offset:128 nt
    buffer_load_dwordx4 v[72:75], v1, s[20:23], s40 offen offset:256 nt
    s_add_u32 s40, s40, 12288
    v_lshlrev_b32 v2, 16, v61
    s_waitcnt vmcnt(9)
    v_dot2_f32_bf16 v24, v76, v61, v24
    v_dot2_f32_bf16 v25, v76, v2, v25
    v_dot2_f32_bf16 v26, v77, v61, v26
    v_dot2_f32_bf16 v27, v77, v2, v27
    v_dot2_f32_bf16 v28, v78, v61, v28
    v_dot2_f32_bf16 v29, v78, v2, v29
    v_dot2_f32_bf16 v30, v79, v61, v30
    v_dot2_f32_bf16 v31, v79, v2, v31
    v_dot2_f32_bf16 v32, v80, v61, v32
    v_dot2_f32_bf16 v33, v80, v2, v33
    v_dot2_f32_bf16 v34, v81, v61, v34
    v_dot2_f32_bf16 v35, v81, v2, v35
    v_dot2_f32_bf16 v36, v82, v61, v36
    v_dot2_f32_bf16 v37, v82, v2, v37
    v_dot2_f32_bf16 v38, v83, v61, v38
    v_dot2_f32_bf16 v39, v83, v2, v39
    v_dot2_f32_bf16 v40, v84, v61, v40
    v_dot2_f32_bf16 v41, v84, v2, v41
    v_dot2_f32_bf16 v42, v85, v61, v42
    v_dot2_f32_bf16 v43, v85, v2, v43
    v_dot2_f32_bf16 v44, v86, v61, v44
    v_dot2_f32_bf16 v45, v86, v2, v45
    v_dot2_f32_bf16 v46, v87, v61, v46
    v_dot2_f32_bf16 v47, v87, v2, v47
    buffer_load_dwordx4 v[76:79], v1, s[20:23], s40 offen offset:0 nt
    buffer_load_dwordx4 v[80:83], v1, s[20:23], s40 offen offset:128 nt
    buffer_load_dwordx4 v[84:87], v1, s[20:23], s40 offen offset:256 nt
    s_add_u32 s40, s40, 12288
    v_lshlrev_b32 v2, 16, v62
    s_waitcnt vmcnt(9)
    v_dot2_f32_bf16 v24, v88, v62, v24
    v_dot2_f32_bf16 v25, v88, v2, v25
    v_dot2_f32_bf16 v26, v89, v62, v26
    v_dot2_f32_bf16 v27, v89, v2, v27
    v_dot2_f32_bf16 v28, v90, v62, v28
    v_dot2_f32_bf16 v29, v90, v2, v29
    v_dot2_f32_bf16 v30, v91, v62, v30
    v_dot2_f32_bf16 v31, v91, v2, v31
    v_dot2_f32_bf16 v32, v92, v62, v32
    v_dot2_f32_bf16 v33, v92, v2, v33
    v_dot2_f32_bf16 v34, v93, v62, v34
    v_dot2_f32_bf16 v35, v93, v2, v35
    v_dot2_f32_bf16 v36, v94, v62, v36
    v_dot2_f32_bf16 v37, v94, v2, v37
    v_dot2_f32_bf16 v38, v95, v62, v38
    v_dot2_f32_bf16 v39, v95, v2, v39
    v_dot2_f32_bf16 v40, v96, v62, v40
    v_dot2_f32_bf16 v41, v96, v2, v41
    v_dot2_f32_bf16 v42, v97, v62, v42
    v_dot2_f32_bf16 v43, v97, v2, v43
    v_dot2_f32_bf16 v44, v98, v62, v44
    v_dot2_f32_bf16 v45, v98, v2, v45
    v_dot2_f32_bf16 v46, v99, v62, v46
    v_dot2_f32_bf16 v47, v99, v2, v47
    buffer_load_dwordx4 v[88:91], v1, s[20:23], s40 offen offset:0 nt
    buffer_load_dwordx4 v[92:95], v1, s[20:23], s40 offen offset:128 nt
    buffer_load_dwordx4 v[96:99], v1, s[20:23], s40 offen offset:256 nt
    s_add_u32 s40, s40, 12288
    v_lshlrev_b32 v2, 16, v63
    s_waitcnt vmcnt(9)
    v_dot2_f32_bf16 v24, v100, v63, v24
    v_dot2_f32_bf16 v25, v100, v2, v25
    v_dot2_f32_bf16 v26, v101, v63, v26
    v_dot2_f32_bf16 v27, v101, v2, v27
    v_dot2_f32_bf16 v28, v102, v63, v28
    v_dot2_f32_bf16 v29, v102, v2, v29
    v_dot2_f32_bf16 v30, v103, v63, v30
    v_dot2_f32_bf16 v31, v103, v2, v31
    v_dot2_f32_bf16 v32, v104, v63, v32
    v_dot2_f32_bf16 v33, v104, v2, v33
    v_dot2_f32_bf16 v34, v105, v63, v34
    v_dot2_f32_bf16 v35, v105, v2, v35
    v_dot2_f32_bf16 v36, v106, v63, v36
    v_dot2_f32_bf16 v37, v106, v2, v37
    v_dot2_f32_bf16 v38, v107, v63, v38
    v_dot2_f32_bf16 v39, v107, v2, v39
    v_dot2_f32_bf16 v40, v108, v63, v40
    v_dot2_f32_bf16 v41, v108, v2, v41
    v_dot2_f32_bf16 v42, v109, v63, v42
    v_dot2_f32_bf16 v43, v109, v2, v43
    v_dot2_f32_bf16 v44, v110, v63, v44
    v_dot2_f32_bf16 v45, v110, v2, v45
    v_dot2_f32_bf16 v46, v111, v63, v46
    v_dot2_f32_bf16 v47, v111, v2, v47
    buffer_load_dwordx4 v[100:103], v1, s[20:23], s40 offen offset:0 nt
    buffer_load_dwordx4 v[104:107], v1, s[20:23], s40 offen offset:128 nt
    buffer_load_dwordx4 v[108:111], v1, s[20:23], s40 offen offset:256 nt
    s_add_u32 s40, s40, 12288
    s_add_u32 s41, s41, 1
    s_cmp_lt_u32 s41, 15
    s_cbranch_scc1 L_vloop
    s_waitcnt lgkmcnt(0)
    v_mov_b32 v60, v56
    v_mov_b32 v61, v57
    v_mov_b32 v62, v58
    v_mov_b32 v63, v59
    v_lshlrev_b32 v2, 16, v60
    s_waitcnt vmcnt(9)
    v_dot2_f32_bf16 v24, v64, v60, v24
    v_dot2_f32_bf16 v25, v64, v2, v25
    v_dot2_f32_bf16 v26, v65, v60, v26
    v_dot2_f32_bf16 v27, v65, v2, v27
    v_dot2_f32_bf16 v28, v66, v60, v28
    v_dot2_f32_bf16 v29, v66, v2, v29
    v_dot2_f32_bf16 v30, v67, v60, v30
    v_dot2_f32_bf16 v31, v67, v2, v31
    v_dot2_f32_bf16 v32, v68, v60, v32
    v_dot2_f32_bf16 v33, v68, v2, v33
    v_dot2_f32_bf16 v34, v69, v60, v34
    v_dot2_f32_bf16 v35, v69, v2, v35
    v_dot2_f32_bf16 v36, v70, v60, v36
    v_dot2_f32_bf16 v37, v70, v2, v37
    v_dot2_f32_bf16 v38, v71, v60, v38
    v_dot2_f32_bf16 v39, v71, v2, v39
    v_dot2_f32_bf16 v40, v72, v60, v40
    v_dot2_f32_bf16 v41, v72, v2, v41
    v_dot2_f32_bf16 v42, v73, v60, v42
    v_dot2_f32_bf16 v43, v73, v2, v43
    v_dot2_f32_bf16 v44, v74, v60, v44
    v_dot2_f32_bf16 v45, v74, v2, v45
    v_dot2_f32_bf16 v46, v75, v60, v46
    v_dot2_f32_bf16 v47, v75, v2, v47
    v_lshlrev_b32 v2, 16, v61
    s_waitcnt vmcnt(6)
    v_dot2_f32_bf16 v24, v76, v61, v24
    v_dot2_f32_bf16 v25, v76, v2, v25
    v_dot2_f32_bf16 v26, v77, v61, v26
    v_dot2_f32_bf16 v27, v77, v2, v27
    v_dot2_f32_bf16 v28, v78, v61, v28
    v_dot2_f32_bf16 v29, v78, v2, v29
    v_dot2_f32_bf16 v30, v79, v61, v30
    v_dot2_f32_bf16 v31, v79, v2, v31
    v_dot2_f32_bf16 v32, v80, v61, v32
    v_dot2_f32_bf16 v33, v80, v2, v33
    v_dot2_f32_bf16 v34, v81, v61, v34
    v_dot2_f32_bf16 v35, v81, v2, v35
    v_dot2_f32_bf16 v36, v82, v61, v36
    v_dot2_f32_bf16 v37, v82, v2, v37
    v_dot2_f32_bf16 v38, v83, v61, v38
    v_dot2_f32_bf16 v39, v83, v2, v39
    v_dot2_f32_bf16 v40, v84, v61, v40
    v_dot2_f32_bf16 v41, v84, v2, v41
    v_dot2_f32_bf16 v42, v85, v61, v42
    v_dot2_f32_bf16 v43, v85, v2, v43
    v_dot2_f32_bf16 v44, v86, v61, v44
    v_dot2_f32_bf16 v45, v86, v2, v45
    v_dot2_f32_bf16 v46, v87, v61, v46
    v_dot2_f32_bf16 v47, v87, v2, v47
    v_lshlrev_b32 v2, 16, v62
    s_waitcnt vmcnt(3)
    v_dot2_f32_bf16 v24, v88, v62, v24
    v_dot2_f32_bf16 v25, v88, v2, v25
    v_dot2_f32_bf16 v26, v89, v62, v26
    v_dot2_f32_bf16 v27, v89, v2, v27
    v_dot2_f32_bf16 v28, v90, v62, v28
    v_dot2_f32_bf16 v29, v90, v2, v29
    v_dot2_f32_bf16 v30, v91, v62, v30
    v_dot2_f32_bf16 v31, v91, v2, v31
    v_dot2_f32_bf16 v32, v92, v62, v32
    v_dot2_f32_bf16 v33, v92, v2, v33
    v_dot2_f32_bf16 v34, v93, v62, v34
    v_dot2_f32_bf16 v35, v93, v2, v35
    v_dot2_f32_bf16 v36, v94, v62, v36
    v_dot2_f32_bf16 v37, v94, v2, v37
    v_dot2_f32_bf16 v38, v95, v62, v38
    v_dot2_f32_bf16 v39, v95, v2, v39
    v_dot2_f32_bf16 v40, v96, v62, v40
    v_dot2_f32_bf16 v41, v96, v2, v41
    v_dot2_f32_bf16 v42, v97, v62, v42
    v_dot2_f32_bf16 v43, v97, v2, v43
    v_dot2_f32_bf16 v44, v98, v62, v44
    v_dot2_f32_bf16 v45, v98, v2, v45
    v_dot2_f32_bf16 v46, v99, v62, v46
    v_dot2_f32_bf16 v47, v99, v2, v47
    v_lshlrev_b32 v2, 16, v63
    s_waitcnt vmcnt(0)
    v_dot2_f32_bf16 v24, v100, v63, v24
    v_dot2_f32_bf16 v25, v100, v2, v25
    v_dot2_f32_bf16 v26, v101, v63, v26
    v_dot2_f32_bf16 v27, v101, v2, v27
    v_dot2_f32_bf16 v28, v102, v63, v28
    v_dot2_f32_bf16 v29, v102, v2, v29
    v_dot2_f32_bf16 v30, v103, v63, v30
    v_dot2_f32_bf16 v31, v103, v2, v31
    v_dot2_f32_bf16 v32, v104, v63, v32
    v_dot2_f32_bf16 v33, v104, v2, v33
    v_dot2_f32_bf16 v34, v105, v63, v34
    v_dot2_f32_bf16 v35, v105, v2, v35
    v_dot2_f32_bf16 v36, v106, v63, v36
    v_dot2_f32_bf16 v37, v106, v2, v37
    v_dot2_f32_bf16 v38, v107, v63, v38
    v_dot2_f32_bf16 v39, v107, v2, v39
    v_dot2_f32_bf16 v40, v108, v63, v40
    v_dot2_f32_bf16 v41, v108, v2, v41
    v_dot2_f32_bf16 v42, v109, v63, v42
    v_dot2_f32_bf16 v43, v109, v2, v43
    v_dot2_f32_bf16 v44, v110, v63, v44
    v_dot2_f32_bf16 v45, v110, v2, v45
    v_dot2_f32_bf16 v46, v111, v63, v46
    v_dot2_f32_bf16 v47, v111, v2, v47
    s_nop 2
    v_add_f32_dpp v24, v24, v24 row_ror:8 row_mask:0xf bank_mask:0xf
    v_add_f32_dpp v25, v25, v25 row_ror:8 row_mask:0xf bank_mask:0xf
    v_add_f32_dpp v26, v26, v26 row_ror:8 row_mask:0xf bank_mask:0xf
    v_add_f32_dpp v27, v27, v27 row_ror:8 row_mask:0xf bank_mask:0xf
    v_add_f32_dpp v28, v28, v28 row_ror:8 row_mask:0xf bank_mask:0xf
    v_add_f32_dpp v29, v29, v29 row_ror:8 row_mask:0xf bank_mask:0xf
    v_add_f32_dpp v30, v30, v30 row_ror:8 row_mask:0xf bank_mask:0xf
    v_add_f32_dpp v31, v31, v31 row_ror:8 row_mask:0xf bank_mask:0xf
    v_add_f32_dpp v32, v32, v32 row_ror:8 row_mask:0xf bank_mask:0xf
    v_add_f32_dpp v33, v33, v33 row_ror:8 row_mask:0xf bank_mask:0xf
    v_add_f32_dpp v34, v34, v34 row_ror:8 row_mask:0xf bank_mask:0xf
    v_add_f32_dpp v35, v35, v35 row_ror:8 row_mask:0xf bank_mask:0xf
    v_add_f32_dpp v36, v36, v36 row_ror:8 row_mask:0xf bank_mask:0xf
    v_add_f32_dpp v37, v37, v37 row_ror:8 row_mask:0xf bank_mask:0xf
    v_add_f32_dpp v38, v38, v38 row_ror:8 row_mask:0xf bank_mask:0xf
    v_add_f32_dpp v39, v39, v39 row_ror:8 row_mask:0xf bank_mask:0xf
    v_add_f32_dpp v40, v40, v40 row_ror:8 row_mask:0xf bank_mask:0xf
    v_add_f32_dpp v41, v41, v41 row_ror:8 row_mask:0xf bank_mask:0xf
    v_add_f32_dpp v42, v42, v42 row_ror:8 row_mask:0xf bank_mask:0xf
    v_add_f32_dpp v43, v43, v43 row_ror:8 row_mask:0xf bank_mask:0xf
    v_add_f32_dpp v44, v44, v44 row_ror:8 row_mask:0xf bank_mask:0xf
    v_add_f32_dpp v45, v45, v45 row_ror:8 row_mask:0xf bank_mask:0xf
    v_add_f32_dpp v46, v46, v46 row_ror:8 row_mask:0xf bank_mask:0xf
    v_add_f32_dpp v47, v47, v47 row_ror:8 row_mask:0xf bank_mask:0xf
    v_mov_b32 v64, v24
    v_mov_b32 v65, v25
    v_mov_b32 v66, v26
    v_mov_b32 v67, v27
    v_mov_b32 v68, v28
    v_mov_b32 v69, v29
    v_mov_b32 v70, v30
    v_mov_b32 v71, v31
    v_mov_b32 v72, v32
    v_mov_b32 v73, v33
    v_mov_b32 v74, v34
    v_mov_b32 v75, v35
    v_mov_b32 v76, v36
    v_mov_b32 v77, v37
    v_mov_b32 v78, v38
    v_mov_b32 v79, v39
    v_mov_b32 v80, v40
    v_mov_b32 v81, v41
    v_mov_b32 v82, v42
    v_mov_b32 v83, v43
    v_mov_b32 v84, v44
    v_mov_b32 v85, v45
    v_mov_b32 v86, v46
    v_mov_b32 v87, v47
    s_nop 1
    v_permlane16_swap_b32 v64, v24
    v_permlane16_swap_b32 v65, v25
    v_permlane16_swap_b32 v66, v26
    v_permlane16_swap_b32 v67, v27
    v_permlane16_swap_b32 v68, v28
    v_permlane16_swap_b32 v69, v29
    v_permlane16_swap_b32 v70, v30
    v_permlane16_swap_b32 v71, v31
    v_permlane16_swap_b32 v72, v32
    v_permlane16_swap_b32 v73, v33
    v_permlane16_swap_b32 v74, v34
    v_permlane16_swap_b32 v75, v35
    v_permlane16_swap_b32 v76, v36
    v_permlane16_swap_b32 v77, v37
    v_permlane16_swap_b32 v78, v38
    v_permlane16_swap_b32 v79, v39
    v_permlane16_swap_b32 v80, v40
    v_permlane16_swap_b32 v81, v41
    v_permlane16_swap_b32 v82, v42
    v_permlane16_swap_b32 v83, v43
    v_permlane16_swap_b32 v84, v44
    v_permlane16_swap_b32 v85, v45
    v_permlane16_swap_b32 v86, v46
    v_permlane16_swap_b32 v87, v47
    s_nop 1
    v_add_f32 v24, v24, v64
    v_add_f32 v25, v25, v65
    v_add_f32 v26, v26, v66
    v_add_f32 v27, v27, v67
    v_add_f32 v28, v28, v68
    v_add_f32 v29, v29, v69
    v_add_f32 v30, v30, v70
    v_add_f32 v31, v31, v71
    v_add_f32 v32, v32, v72
    v_add_f32 v33, v33, v73
    v_add_f32 v34, v34, v74
    v_add_f32 v35, v35, v75
    v_add_f32 v36, v36, v76
    v_add_f32 v37, v37, v77
    v_add_f32 v38, v38, v78
    v_add_f32 v39, v39, v79
    v_add_f32 v40, v40, v80
    v_add_f32 v41, v41, v81
    v_add_f32 v42, v42, v82
    v_add_f32 v43, v43, v83
    v_add_f32 v44, v44, v84
    v_add_f32 v45, v45, v85
    v_add_f32 v46, v46, v86
    v_add_f32 v47, v47, v87
    v_mov_b32 v64, v24
    v_mov_b32 v65, v25
    v_mov_b32 v66, v26
    v_mov_b32 v67, v27
    v_mov_b32 v68, v28
    v_mov_b32 v69, v29
    v_mov_b32 v70, v30
    v_mov_b32 v71, v31
    v_mov_b32 v72, v32
    v_mov_b32 v73, v33
    v_mov_b32 v74, v34
    v_mov_b32 v75, v35
    v_mov_b32 v76, v36
    v_mov_b32 v77, v37
    v_mov_b32 v78, v38
    v_mov_b32 v79, v39
    v_mov_b32 v80, v40
    v_mov_b32 v81, v41
    v_mov_b32 v82, v42
    v_mov_b32 v83, v43
    v_mov_b32 v84, v44
    v_mov_b32 v85, v45
    v_mov_b32 v86, v46
    v_mov_b32 v87, v47
    s_nop 1
    v_permlane32_swap_b32 v64, v24
    v_permlane32_swap_b32 v65, v25
    v_permlane32_swap_b32 v66, v26
    v_permlane32_swap_b32 v67, v27
    v_permlane32_swap_b32 v68, v28
    v_permlane32_swap_b32 v69, v29
    v_permlane32_swap_b32 v70, v30
    v_permlane32_swap_b32 v71, v31
    v_permlane32_swap_b32 v72, v32
    v_permlane32_swap_b32 v73, v33
    v_permlane32_swap_b32 v74, v34
    v_permlane32_swap_b32 v75, v35
    v_permlane32_swap_b32 v76, v36
    v_permlane32_swap_b32 v77, v37
    v_permlane32_swap_b32 v78, v38
    v_permlane32_swap_b32 v79, v39
    v_permlane32_swap_b32 v80, v40
    v_permlane32_swap_b32 v81, v41
    v_permlane32_swap_b32 v82, v42
    v_permlane32_swap_b32 v83, v43
    v_permlane32_swap_b32 v84, v44
    v_permlane32_swap_b32 v85, v45
    v_permlane32_swap_b32 v86, v46
    v_permlane32_swap_b32 v87, v47
    s_nop 1
    v_add_f32 v24, v24, v64
    v_add_f32 v25, v25, v65
    v_add_f32 v26, v26, v66
    v_add_f32 v27, v27, v67
    v_add_f32 v28, v28, v68
    v_add_f32 v29, v29, v69
    v_add_f32 v30, v30, v70
    v_add_f32 v31, v31, v71
    v_add_f32 v32, v32, v72
    v_add_f32 v33, v33, v73
    v_add_f32 v34, v34, v74
    v_add_f32 v35, v35, v75
    v_add_f32 v36, v36, v76
    v_add_f32 v37, v37, v77
    v_add_f32 v38, v38, v78
    v_add_f32 v39, v39, v79
    v_add_f32 v40, v40, v80
    v_add_f32 v41, v41, v81
    v_add_f32 v42, v42, v82
    v_add_f32 v43, v43, v83
    v_add_f32 v44, v44, v84
    v_add_f32 v45, v45, v85
    v_add_f32 v46, v46, v86
    v_add_f32 v47, v47, v87
    s_lshl_b32 s52, s3, 10
    v_and_b32 v2, 7, v7
    v_lshlrev_b32 v2, 5, v2
    v_add_u32 v2, s52, v2
    v_cmp_gt_u32 vcc, 8, v7
    s_and_saveexec_b64 s[54:55], vcc
    ds_write_b128 v2, v[24:27] offset:8192
    ds_write_b128 v2, v[28:31] offset:8208
    ds_write_b128 v2, v[32:35] offset:8448
    ds_write_b128 v2, v[36:39] offset:8464
    ds_write_b128 v2, v[40:43] offset:8704
    ds_write_b128 v2, v[44:47] offset:8720
    v_mov_b32 v3, s52
    ds_write_b32 v3, v9 offset:8960
    ds_write_b32 v3, v8 offset:8964
    s_mov_b64 exec, s[54:55]
    s_waitcnt lgkmcnt(0)
    s_barrier
    v_cmp_gt_u32 vcc, 192, v0
    s_and_saveexec_b64 s[54:55], vcc
    s_cbranch_execz L_end1
    v_mov_b32 v2, 0
    ds_read_b64 v[64:65], v2 offset:8960
    ds_read_b64 v[66:67], v2 offset:9984
    ds_read_b64 v[68:69], v2 offset:11008
    ds_read_b64 v[70:71], v2 offset:12032
    v_lshlrev_b32 v3, 2, v0
    ds_read_b32 v24, v3 offset:8192
    ds_read_b32 v25, v3 offset:9216
    ds_read_b32 v26, v3 offset:10240
    ds_read_b32 v27, v3 offset:11264
    s_waitcnt lgkmcnt(0)
    v_max_f32 v9, v64, v66
    v_max_f32 v9, v9, v68
    v_max_f32 v9, v9, v70
    v_mul_f32 v4, s50, v9
    v_fma_f32 v64, v64, s50, -v4
    v_fma_f32 v66, v66, s50, -v4
    v_fma_f32 v68, v68, s50, -v4
    v_fma_f32 v70, v70, s50, -v4
    v_exp_f32 v64, v64
    v_exp_f32 v66, v66
    v_exp_f32 v68, v68
    v_exp_f32 v70, v70
    s_nop 0
    v_mul_f32 v5, v64, v65
    v_mul_f32 v4, v64, v24
    v_fma_f32 v5, v66, v67, v5
    v_fma_f32 v4, v66, v25, v4
    v_fma_f32 v5, v68, v69, v5
    v_fma_f32 v4, v68, v26, v4
    v_fma_f32 v5, v70, v71, v5
    v_fma_f32 v4, v70, v27, v4
    s_lshl_b32 s48, s2, 10
    buffer_store_dword v4, v3, s[28:31], s48 offen
    v_cmp_eq_u32 vcc, 0, v0
    s_and_b64 exec, exec, vcc
    v_mov_b32 v8, v9
    v_mov_b32 v9, v5
    buffer_store_dwordx2 v[8:9], v3, s[28:31], s48 offen offset:768
L_end1:
    s_endpgm
.globl combine_kernel
.p2align 8
.type combine_kernel,@function
combine_kernel:
    s_cmp_ge_u32 s2, 32
    s_cbranch_scc1 L_end2
    s_load_dwordx2 s[4:5], s[0:1], 24
    s_load_dwordx2 s[10:11], s[0:1], 40
    v_cmp_gt_u32 vcc, 192, v0
    s_and_saveexec_b64 s[44:45], vcc
    s_cbranch_execz L_end2
    v_lshlrev_b32 v1, 2, v0
    v_mov_b32 v2, 0
    s_mov_b32 s42, 0x3dd53b95
    s_mul_i32 s40, s2, 16384
    s_waitcnt lgkmcnt(0)
    s_mov_b32 s28, s10
    s_and_b32 s29, s11, 0xffff
    s_mov_b32 s30, 524288
    s_mov_b32 s31, 0x20000
    s_mov_b32 s16, s4
    s_and_b32 s17, s5, 0xffff
    s_mov_b32 s18, 12288
    s_mov_b32 s19, 0x20000
    s_add_u32 s41, s40, 0
    buffer_load_dword v10, v1, s[28:31], s41 offen offset:0
    buffer_load_dwordx2 v[26:27], v2, s[28:31], s41 offen offset:768
    buffer_load_dword v11, v1, s[28:31], s41 offen offset:1024
    buffer_load_dwordx2 v[28:29], v2, s[28:31], s41 offen offset:1792
    buffer_load_dword v12, v1, s[28:31], s41 offen offset:2048
    buffer_load_dwordx2 v[30:31], v2, s[28:31], s41 offen offset:2816
    buffer_load_dword v13, v1, s[28:31], s41 offen offset:3072
    buffer_load_dwordx2 v[32:33], v2, s[28:31], s41 offen offset:3840
    s_add_u32 s41, s40, 4096
    buffer_load_dword v14, v1, s[28:31], s41 offen offset:0
    buffer_load_dwordx2 v[34:35], v2, s[28:31], s41 offen offset:768
    buffer_load_dword v15, v1, s[28:31], s41 offen offset:1024
    buffer_load_dwordx2 v[36:37], v2, s[28:31], s41 offen offset:1792
    buffer_load_dword v16, v1, s[28:31], s41 offen offset:2048
    buffer_load_dwordx2 v[38:39], v2, s[28:31], s41 offen offset:2816
    buffer_load_dword v17, v1, s[28:31], s41 offen offset:3072
    buffer_load_dwordx2 v[40:41], v2, s[28:31], s41 offen offset:3840
    s_add_u32 s41, s40, 8192
    buffer_load_dword v18, v1, s[28:31], s41 offen offset:0
    buffer_load_dwordx2 v[42:43], v2, s[28:31], s41 offen offset:768
    buffer_load_dword v19, v1, s[28:31], s41 offen offset:1024
    buffer_load_dwordx2 v[44:45], v2, s[28:31], s41 offen offset:1792
    buffer_load_dword v20, v1, s[28:31], s41 offen offset:2048
    buffer_load_dwordx2 v[46:47], v2, s[28:31], s41 offen offset:2816
    buffer_load_dword v21, v1, s[28:31], s41 offen offset:3072
    buffer_load_dwordx2 v[48:49], v2, s[28:31], s41 offen offset:3840
    s_add_u32 s41, s40, 12288
    buffer_load_dword v22, v1, s[28:31], s41 offen offset:0
    buffer_load_dwordx2 v[50:51], v2, s[28:31], s41 offen offset:768
    buffer_load_dword v23, v1, s[28:31], s41 offen offset:1024
    buffer_load_dwordx2 v[52:53], v2, s[28:31], s41 offen offset:1792
    buffer_load_dword v24, v1, s[28:31], s41 offen offset:2048
    buffer_load_dwordx2 v[54:55], v2, s[28:31], s41 offen offset:2816
    buffer_load_dword v25, v1, s[28:31], s41 offen offset:3072
    buffer_load_dwordx2 v[56:57], v2, s[28:31], s41 offen offset:3840
    s_waitcnt vmcnt(0)
    v_max_f32 v3, v26, v28
    v_max_f32 v3, v3, v30
    v_max_f32 v3, v3, v32
    v_max_f32 v3, v3, v34
    v_max_f32 v3, v3, v36
    v_max_f32 v3, v3, v38
    v_max_f32 v3, v3, v40
    v_max_f32 v3, v3, v42
    v_max_f32 v3, v3, v44
    v_max_f32 v3, v3, v46
    v_max_f32 v3, v3, v48
    v_max_f32 v3, v3, v50
    v_max_f32 v3, v3, v52
    v_max_f32 v3, v3, v54
    v_max_f32 v3, v3, v56
    v_mul_f32 v4, s42, v3
    v_fma_f32 v26, v26, s42, -v4
    v_fma_f32 v28, v28, s42, -v4
    v_fma_f32 v30, v30, s42, -v4
    v_fma_f32 v32, v32, s42, -v4
    v_fma_f32 v34, v34, s42, -v4
    v_fma_f32 v36, v36, s42, -v4
    v_fma_f32 v38, v38, s42, -v4
    v_fma_f32 v40, v40, s42, -v4
    v_fma_f32 v42, v42, s42, -v4
    v_fma_f32 v44, v44, s42, -v4
    v_fma_f32 v46, v46, s42, -v4
    v_fma_f32 v48, v48, s42, -v4
    v_fma_f32 v50, v50, s42, -v4
    v_fma_f32 v52, v52, s42, -v4
    v_fma_f32 v54, v54, s42, -v4
    v_fma_f32 v56, v56, s42, -v4
    v_exp_f32 v26, v26
    v_exp_f32 v28, v28
    v_exp_f32 v30, v30
    v_exp_f32 v32, v32
    v_exp_f32 v34, v34
    v_exp_f32 v36, v36
    v_exp_f32 v38, v38
    v_exp_f32 v40, v40
    v_exp_f32 v42, v42
    v_exp_f32 v44, v44
    v_exp_f32 v46, v46
    v_exp_f32 v48, v48
    v_exp_f32 v50, v50
    v_exp_f32 v52, v52
    v_exp_f32 v54, v54
    v_exp_f32 v56, v56
    s_nop 0
    v_mul_f32 v5, v26, v27
    v_mul_f32 v6, v26, v10
    v_fma_f32 v5, v28, v29, v5
    v_fma_f32 v6, v28, v11, v6
    v_fma_f32 v5, v30, v31, v5
    v_fma_f32 v6, v30, v12, v6
    v_fma_f32 v5, v32, v33, v5
    v_fma_f32 v6, v32, v13, v6
    v_fma_f32 v5, v34, v35, v5
    v_fma_f32 v6, v34, v14, v6
    v_fma_f32 v5, v36, v37, v5
    v_fma_f32 v6, v36, v15, v6
    v_fma_f32 v5, v38, v39, v5
    v_fma_f32 v6, v38, v16, v6
    v_fma_f32 v5, v40, v41, v5
    v_fma_f32 v6, v40, v17, v6
    v_fma_f32 v5, v42, v43, v5
    v_fma_f32 v6, v42, v18, v6
    v_fma_f32 v5, v44, v45, v5
    v_fma_f32 v6, v44, v19, v6
    v_fma_f32 v5, v46, v47, v5
    v_fma_f32 v6, v46, v20, v6
    v_fma_f32 v5, v48, v49, v5
    v_fma_f32 v6, v48, v21, v6
    v_fma_f32 v5, v50, v51, v5
    v_fma_f32 v6, v50, v22, v6
    v_fma_f32 v5, v52, v53, v5
    v_fma_f32 v6, v52, v23, v6
    v_fma_f32 v5, v54, v55, v5
    v_fma_f32 v6, v54, v24, v6
    v_fma_f32 v5, v56, v57, v5
    v_fma_f32 v6, v56, v25, v6
    v_rcp_f32 v5, v5
    s_nop 0
    v_mul_f32 v6, v6, v5
    v_cvt_pk_bf16_f32 v6, v6, v6
    v_lshlrev_b32 v1, 1, v0
    s_mul_i32 s41, s2, 384
    buffer_store_short v6, v1, s[16:19], s41 offen
L_end2:
    s_endpgm
.section .rodata,"a"
.p2align 6
.amdhsa_kernel standalone__softmax_full_bidir__decode_kernel
  .amdhsa_next_free_vgpr 112
  .amdhsa_next_free_sgpr 64
  .amdhsa_accum_offset 112
  .amdhsa_group_segment_fixed_size 0
  .amdhsa_kernarg_size 48
  .amdhsa_user_sgpr_count 2
  .amdhsa_user_sgpr_kernarg_segment_ptr 1
  .amdhsa_system_sgpr_workgroup_id_x 1
.end_amdhsa_kernel
.p2align 6
.amdhsa_kernel combine_kernel
  .amdhsa_next_free_vgpr 60
  .amdhsa_next_free_sgpr 64
  .amdhsa_accum_offset 60
  .amdhsa_group_segment_fixed_size 0
  .amdhsa_kernarg_size 48
  .amdhsa_user_sgpr_count 2
  .amdhsa_user_sgpr_kernarg_segment_ptr 1
  .amdhsa_system_sgpr_workgroup_id_x 1
.end_amdhsa_kernel
```
